```python
import torch

def _softmax(x, axis=-1):
    return torch.softmax(x, dim=axis)
def _gelu(x):
    return torch.nn.functional.gelu(x, approximate="tanh")
def _silu(x):
    return torch.nn.functional.silu(x)
def _sigmoid(x):
    return torch.sigmoid(x)
def _layernorm(x, axis=-1, eps=1e-5):
    m = x.mean(dim=axis, keepdim=True)
    v = x.var(dim=axis, keepdim=True, unbiased=False)
    return (x - m) / torch.sqrt(v + eps)
def _scatter_add(tgt, idx, src, axis=0):
    return tgt.clone().index_add_(axis, idx, src)
def _segment_sum(src, seg, n):
    out = torch.zeros((n,) + src.shape[1:], dtype=src.dtype)
    return out.index_add_(0, seg, src)
def _pad(x, pw):
    flat = tuple(v for pair in reversed(pw) for v in pair)
    return torch.nn.functional.pad(x, flat)

kernel_name = 'recurrent_scan__sliding_block_cached__swiglu_ffn__decode'

def setup_inputs():

    _w = (lambda a: (lambda t: t.to(torch.bfloat16) if t.is_floating_point() else t)(torch.as_tensor(a)))
    def _A_setup():
        B, Sq, D = 1, 1, 576
        Hq, Hkv, Sk, Dh = 32, 16, 8192, 128
        assert Hq % Hkv == 0, (Hq, Hkv)
        return {
            "x": _w((lambda *s: torch.randn(*s, dtype=torch.bfloat16) * 0.05)(B, Sq, D)),
            "k_cache": _w((lambda *s: torch.randn(*s, dtype=torch.bfloat16) * 0.8)(B, Hkv, Sk, Dh)),
            "v_cache": _w((lambda *s: torch.randn(*s, dtype=torch.bfloat16) * 0.2)(B, Hkv, Sk, Dh)),
            "wq": _w((lambda *s: torch.randn(*s, dtype=torch.bfloat16) * 0.8)(D, Hq * Dh) * (D ** -0.5)),
            "wo": _w((lambda *s: torch.randn(*s, dtype=torch.bfloat16) * 0.2)(Hq * Dh, D) * ((Hq * Dh) ** -0.5)),
        }
    _A_in = _A_setup()

    def _B_setup():
        B, S, D, F = 1, 1, 576, 4608
        return {
            "x": _w((lambda *s: torch.randn(*s, dtype=torch.bfloat16) * 0.05)(B, S, D)),
            "w_gate": _w((lambda *s: torch.randn(*s, dtype=torch.bfloat16) * 0.1)(D, F)),
            "w_up": _w((lambda *s: torch.randn(*s, dtype=torch.bfloat16) * 0.1)(D, F)),
            "w_down": _w((lambda *s: torch.randn(*s, dtype=torch.bfloat16) * 0.1)(F, D)),
        }
    _B_in = _B_setup()

    return {
        "A_x": _A_in["x"],
        "A_k_cache": _A_in["k_cache"],
        "A_v_cache": _A_in["v_cache"],
        "A_wq": _A_in["wq"],
        "A_wo": _A_in["wo"],
        "B_x": _B_in["x"],
        "B_w_gate": _B_in["w_gate"],
        "B_w_up": _B_in["w_up"],
        "B_w_down": _B_in["w_down"],
    }

def reference(A_x, A_k_cache, A_v_cache, A_wq, A_wo, B_x, B_w_gate, B_w_up, B_w_down):
    def _A_ref(x, k_cache, v_cache, wq, wo):
        B, Sq, D = x.shape
        Hq, Dh = 32, 128
        Hkv, Sk = k_cache.shape[1], k_cache.shape[2]
        W = min(4096, max(256, Sk // 4))
        rep = Hq // Hkv
        q = (lambda x, *d: x.permute(*d))((x @ wq).reshape(B, Sq, Hq, Dh), 0, 2, 1, 3)
        k = (lambda x, n, axis: torch.repeat_interleave(x, n, dim=axis))(k_cache[:, :, Sk - W:, :], rep, axis=1)
        v = (lambda x, n, axis: torch.repeat_interleave(x, n, dim=axis))(v_cache[:, :, Sk - W:, :], rep, axis=1)
        scores = torch.einsum("bhqd,bhkd->bhqk", q, k) * (Dh ** -0.5)
        p = _softmax(scores, axis=-1)
        o = torch.einsum("bhqk,bhkd->bhqd", p, v)
        return (lambda x, *d: x.permute(*d))(o, 0, 2, 1, 3).reshape(B, Sq, Hq * Dh) @ wo

    def _B_ref(x, w_gate, w_up, w_down):
        g = _silu(x @ w_gate)
        u = x @ w_up
        return (g * u) @ w_down

    x = A_x
    xn = _layernorm(x, axis=-1)
    s = _A_ref(xn, A_k_cache, A_v_cache, A_wq, A_wo)
    g = _silu(_B_ref(xn, B_w_gate, B_w_up, B_w_down))
    return x + s * g
```

```asm
; @launch grid=(512,1,1) block=(576,1,1) lds=65536
.amdgcn_target "amdgcn-amd-amdhsa--gfx950"
.text
.globl recurrent_scan__sliding_block_cached__swiglu_ffn__decode_kernel
.p2align 8
.type recurrent_scan__sliding_block_cached__swiglu_ffn__decode_kernel,@function
recurrent_scan__sliding_block_cached__swiglu_ffn__decode_kernel:
    s_cmp_ge_u32 s2, 512
    s_cbranch_scc1 L_exit
    s_load_dwordx16 s[16:31], s[0:1], 0
    s_load_dwordx8 s[32:39], s[0:1], 64
    s_and_b32 s3, s2, 255
    v_and_b32 v1, 63, v0
    v_lshlrev_b32 v4, 4, v0
    v_lshrrev_b32 v5, 6, v0
    s_nop 0
    v_readfirstlane_b32 s75, v5
    s_waitcnt lgkmcnt(0)
    s_mov_b32 s60, s38
    s_mov_b32 s61, s39
    s_mov_b32 s62, 268435456
    s_mov_b32 s63, 0x00020000
    s_cmp_ge_u32 s2, 256
    s_cbranch_scc1 L_role_kv
    s_lshr_b32 s4, s3, 4
    s_and_b32 s5, s3, 15
    s_lshr_b32 s6, s5, 2
    s_and_b32 s7, s5, 3
    s_mov_b32 s68, 589824
    s_mov_b32 s40, s16
    s_mov_b32 s41, s17
    s_mov_b32 s42, 1152
    s_mov_b32 s43, 0x00020000
    s_mul_i32 s8, s7, 1179648
    s_lshl_b32 s9, s4, 9
    s_add_u32 s8, s8, s9
    s_lshl_b32 s9, s6, 7
    s_add_u32 s8, s8, s9
    s_sub_u32 s10, 4718592, s8
    s_add_u32 s44, s22, s8
    s_addc_u32 s45, s23, 0
    s_mov_b32 s46, s10
    s_mov_b32 s47, 0x00020000
    s_setprio 3
    s_mov_b32 s80, 0xff00ff00
    s_mov_b32 s81, 0xff00ff00
    v_mov_b32 v12, 0
    buffer_load_dwordx2 v[10:11], v12, s[60:63], 0 offen sc1
    v_lshlrev_b32 v5, 1, v0
    v_mov_b32 v6, 0
    buffer_load_ushort v15, v5, s[40:43], 0 offen
    buffer_load_ushort v14, v6, s[40:43], 0 offen
    v_lshrrev_b32 v5, 3, v0
    v_and_b32 v6, 7, v0
    v_lshlrev_b32 v5, 13, v5
    v_lshl_add_u32 v5, v6, 4, v5
    buffer_load_dwordx4 v[36:39], v5, s[44:47], 0 offen nt
    buffer_load_dwordx4 v[40:43], v5, s[44:47], s68 offen nt
    v_lshrrev_b32 v2, 3, v1
    v_and_b32 v3, 7, v1
    s_mov_b32 s69, 73728
    s_mov_b32 s70, 147456
    s_mov_b32 s71, 221184
    s_mov_b32 s72, 294912
    s_mov_b32 s73, 9216
    s_mov_b32 s74, 18432
    s_cmp_lt_u32 s4, 8
    s_cselect_b32 s82, s28, s30
    s_cselect_b32 s83, s29, s31
    s_mul_i32 s8, s5, 331776
    s_and_b32 s9, s4, 7
    s_mul_i32 s9, s9, 1152
    s_add_u32 s8, s8, s9
    s_add_u32 s48, s82, s8
    s_addc_u32 s49, s83, 0
    s_mov_b32 s50, 331776
    s_mov_b32 s51, 0x00020000
    s_mul_i32 s8, s3, 18432
    s_add_u32 s52, s24, s8
    s_addc_u32 s53, s25, 0
    s_mov_b32 s54, 18432
    s_mov_b32 s55, 0x00020000
    s_mul_i32 s8, s3, 20736
    s_add_u32 s56, s32, s8
    s_addc_u32 s57, s33, 0
    s_mov_b32 s58, 20736
    s_mov_b32 s59, 0x00020000
    s_mov_b32 s64, s34
    s_mov_b32 s65, s35
    s_mov_b32 s66, 1152
    s_mov_b32 s67, 0x00020000
    s_waitcnt vmcnt(4)
    v_readfirstlane_b32 s76, v10
    v_readfirstlane_b32 s77, v11
    s_add_u32 s76, s76, 1
    s_addc_u32 s77, s77, 0
    s_waitcnt vmcnt(2)
    v_lshlrev_b32 v58, 16, v15
    v_lshlrev_b32 v59, 16, v14
    v_sub_f32 v56, v58, v59
    v_mul_f32 v57, v56, v56
    s_nop 0
    v_add_f32 v56, v56, v56 row_shr:1
    v_add_f32 v57, v57, v57 row_shr:1
    s_nop 0
    v_add_f32 v56, v56, v56 row_shr:2
    v_add_f32 v57, v57, v57 row_shr:2
    s_nop 0
    v_add_f32 v56, v56, v56 row_shr:4
    v_add_f32 v57, v57, v57 row_shr:4
    s_nop 0
    v_add_f32 v56, v56, v56 row_shr:8
    v_add_f32 v57, v57, v57 row_shr:8
    s_nop 0
    v_add_f32 v56, v56, v56 row_bcast:15 row_mask:0xa
    v_add_f32 v57, v57, v57 row_bcast:15 row_mask:0xa
    s_nop 0
    v_add_f32 v56, v56, v56 row_bcast:31 row_mask:0xc
    v_add_f32 v57, v57, v57 row_bcast:31 row_mask:0xc
    s_lshl_b32 s9, s75, 3
    v_mov_b32 v5, s9
    v_mov_b32 v6, 0
    v_lshlrev_b32 v7, 2, v1
    ds_write_b32 v7, v6 offset:2432
    s_mov_b32 exec_lo, 0
    s_mov_b32 exec_hi, 0x80000000
    ds_write_b64 v5, v[56:57] offset:0
    s_mov_b64 exec, -1
    s_waitcnt lgkmcnt(0)
    s_barrier
    ds_read_b128 v[60:63], v6 offset:0
    ds_read_b128 v[64:67], v6 offset:16
    ds_read_b128 v[68:71], v6 offset:32
    ds_read_b128 v[72:75], v6 offset:48
    ds_read_b64 v[76:77], v6 offset:64
    s_waitcnt lgkmcnt(0)
    v_add_f32 v78, v60, v62
    v_add_f32 v78, v78, v64
    v_add_f32 v78, v78, v66
    v_add_f32 v78, v78, v68
    v_add_f32 v78, v78, v70
    v_add_f32 v78, v78, v72
    v_add_f32 v78, v78, v74
    v_add_f32 v78, v78, v76
    v_add_f32 v79, v61, v63
    v_add_f32 v79, v79, v65
    v_add_f32 v79, v79, v67
    v_add_f32 v79, v79, v69
    v_add_f32 v79, v79, v71
    v_add_f32 v79, v79, v73
    v_add_f32 v79, v79, v75
    v_add_f32 v79, v79, v77
    v_mul_f32 v78, 0x3ae38e39, v78
    v_mul_f32 v79, 0x3ae38e39, v79
    v_fma_f32 v79, -v78, v78, v79
    v_max_f32 v79, 0, v79
    v_add_f32 v78, v78, v59
    v_cvt_pk_bf16_f32 v60, v78, 0
    v_lshlrev_b32 v60, 16, v60
    v_cvt_pk_bf16_f32 v61, v79, 0
    v_lshlrev_b32 v61, 16, v61
    v_add_f32 v61, 0x3727c5ac, v61
    v_cvt_pk_bf16_f32 v61, v61, 0
    v_lshlrev_b32 v61, 16, v61
    v_sqrt_f32 v62, v61
    s_nop 0
    v_cvt_pk_bf16_f32 v62, v62, 0
    v_lshlrev_b32 v62, 16, v62
    v_sub_f32 v63, v58, v60
    v_cvt_pk_bf16_f32 v63, v63, 0
    v_lshlrev_b32 v63, 16, v63
    v_rcp_f32 v64, v62
    s_nop 0
    v_mul_f32 v65, v63, v64
    v_fma_f32 v66, -v65, v62, v63
    v_fma_f32 v65, v66, v64, v65
    v_cvt_pk_bf16_f32 v65, v65, 0
    v_lshlrev_b32 v66, 2, v0
    ds_write_b32 v66, v65 offset:128
    s_waitcnt lgkmcnt(0)
    s_barrier
    v_lshrrev_b32 v60, 3, v0
    v_lshlrev_b32 v60, 2, v60
    s_mul_i32 s8, s7, 576
    v_add_u32 v60, s8, v60
    ds_read_b32 v56, v60 offset:128
    ds_read_b32 v57, v60 offset:416
    s_waitcnt lgkmcnt(0)
    v_lshlrev_b32 v58, 16, v56
    v_lshlrev_b32 v59, 16, v57
    s_waitcnt vmcnt(1)
    v_dot2_f32_bf16 v64, v36, v56, 0
    v_dot2_f32_bf16 v65, v36, v58, 0
    v_dot2_f32_bf16 v66, v37, v56, 0
    v_dot2_f32_bf16 v67, v37, v58, 0
    v_dot2_f32_bf16 v68, v38, v56, 0
    v_dot2_f32_bf16 v69, v38, v58, 0
    v_dot2_f32_bf16 v70, v39, v56, 0
    v_dot2_f32_bf16 v71, v39, v58, 0
    s_waitcnt vmcnt(0)
    v_dot2_f32_bf16 v64, v40, v57, v64
    v_dot2_f32_bf16 v65, v40, v59, v65
    v_dot2_f32_bf16 v66, v41, v57, v66
    v_dot2_f32_bf16 v67, v41, v59, v67
    v_dot2_f32_bf16 v68, v42, v57, v68
    v_dot2_f32_bf16 v69, v42, v59, v69
    v_dot2_f32_bf16 v70, v43, v57, v70
    v_dot2_f32_bf16 v71, v43, v59, v71
    v_permlane32_swap_b32 v64, v65
    v_permlane32_swap_b32 v66, v67
    v_permlane32_swap_b32 v68, v69
    v_permlane32_swap_b32 v70, v71
    v_add_f32 v64, v64, v65
    v_add_f32 v66, v66, v67
    v_add_f32 v68, v68, v69
    v_add_f32 v70, v70, v71
    v_permlane16_swap_b32 v64, v66
    s_nop 0
    v_permlane16_swap_b32 v68, v70
    v_add_f32 v64, v64, v66
    v_add_f32 v68, v68, v70
    s_nop 0
    v_add_f32 v64, v64, v64 row_ror:8
    v_add_f32 v68, v68, v68 row_ror:8
    v_lshrrev_b32 v56, 4, v1
    v_and_b32 v57, 1, v56
    v_lshlrev_b32 v57, 3, v57
    v_lshrrev_b32 v56, 1, v56
    v_lshl_add_u32 v57, v56, 2, v57
    v_and_b32 v56, 7, v1
    v_lshl_add_u32 v57, v56, 5, v57
    s_lshl_b32 s8, s75, 8
    v_add_u32 v57, s8, v57
    ds_write_b32 v57, v64 offset:2816
    ds_write_b32 v57, v68 offset:2832
    s_waitcnt lgkmcnt(0)
    s_barrier
    v_cmp_gt_u32 vcc, 32, v0
    s_and_saveexec_b64 s[12:13], vcc
    s_cbranch_execz L_skip_pubq_1
    v_lshlrev_b32 v5, 3, v0
    ds_read_b64 v[60:61], v5 offset:2816
    ds_read_b64 v[62:63], v5 offset:3072
    ds_read_b64 v[64:65], v5 offset:3328
    ds_read_b64 v[66:67], v5 offset:3584
    ds_read_b64 v[68:69], v5 offset:3840
    ds_read_b64 v[70:71], v5 offset:4096
    ds_read_b64 v[72:73], v5 offset:4352
    ds_read_b64 v[74:75], v5 offset:4608
    ds_read_b64 v[76:77], v5 offset:4864
    s_waitcnt lgkmcnt(0)
    v_add_f32 v56, v60, v62
    v_add_f32 v56, v56, v64
    v_add_f32 v56, v56, v66
    v_add_f32 v56, v56, v68
    v_add_f32 v56, v56, v70
    v_add_f32 v56, v56, v72
    v_add_f32 v56, v56, v74
    v_add_f32 v56, v56, v76
    v_add_f32 v57, v61, v63
    v_add_f32 v57, v57, v65
    v_add_f32 v57, v57, v67
    v_add_f32 v57, v57, v69
    v_add_f32 v57, v57, v71
    v_add_f32 v57, v57, v73
    v_add_f32 v57, v57, v75
    v_add_f32 v57, v57, v77
    s_lshl_b32 s8, s3, 9
    s_add_u32 s8, s8, 4096
    v_mov_b32 v58, s76
    v_mov_b32 v59, s77
    buffer_store_dwordx4 v[56:59], v4, s[60:63], s8 offen sc1
L_skip_pubq_1:
    s_nop 7
    s_mov_b64 exec, -1
    s_setprio 0
    v_mul_u32_u24 v9, 9216, v2
    v_lshl_add_u32 v9, v3, 4, v9
    s_lshl_b32 s8, s75, 7
    v_add_u32 v9, s8, v9
    buffer_load_dwordx4 v[16:19], v9, s[48:51], 0 offen nt
    buffer_load_dwordx4 v[20:23], v9, s[48:51], s69 offen nt
    s_mul_i32 s8, s5, 144
    v_lshlrev_b32 v66, 2, v2
    v_add_u32 v66, s8, v66
    ds_read_b32 v56, v66 offset:128
    ds_read_b32 v57, v66 offset:160
    ds_read_b32 v58, v66 offset:192
    ds_read_b32 v59, v66 offset:224
    ds_read_b32 v60, v66 offset:256
    s_waitcnt lgkmcnt(0)
    v_lshlrev_b32 v61, 16, v56
    v_lshlrev_b32 v62, 16, v57
    v_lshlrev_b32 v63, 16, v58
    v_lshlrev_b32 v64, 16, v59
    v_lshlrev_b32 v65, 16, v60
    s_waitcnt vmcnt(1)
    buffer_load_dwordx4 v[24:27], v9, s[48:51], s70 offen nt
    v_dot2_f32_bf16 v72, v16, v56, 0
    v_dot2_f32_bf16 v73, v16, v61, 0
    v_dot2_f32_bf16 v74, v17, v56, 0
    v_dot2_f32_bf16 v75, v17, v61, 0
    v_dot2_f32_bf16 v76, v18, v56, 0
    v_dot2_f32_bf16 v77, v18, v61, 0
    v_dot2_f32_bf16 v78, v19, v56, 0
    v_dot2_f32_bf16 v79, v19, v61, 0
    s_waitcnt vmcnt(1)
    buffer_load_dwordx4 v[28:31], v9, s[48:51], s71 offen nt
    v_dot2_f32_bf16 v72, v20, v57, v72
    v_dot2_f32_bf16 v73, v20, v62, v73
    v_dot2_f32_bf16 v74, v21, v57, v74
    v_dot2_f32_bf16 v75, v21, v62, v75
    v_dot2_f32_bf16 v76, v22, v57, v76
    v_dot2_f32_bf16 v77, v22, v62, v77
    v_dot2_f32_bf16 v78, v23, v57, v78
    v_dot2_f32_bf16 v79, v23, v62, v79
    s_waitcnt vmcnt(1)
    buffer_load_dwordx4 v[32:35], v9, s[48:51], s72 offen nt
    v_dot2_f32_bf16 v72, v24, v58, v72
    v_dot2_f32_bf16 v73, v24, v63, v73
    v_dot2_f32_bf16 v74, v25, v58, v74
    v_dot2_f32_bf16 v75, v25, v63, v75
    v_dot2_f32_bf16 v76, v26, v58, v76
    v_dot2_f32_bf16 v77, v26, v63, v77
    v_dot2_f32_bf16 v78, v27, v58, v78
    v_dot2_f32_bf16 v79, v27, v63, v79
    s_waitcnt vmcnt(1)
    v_dot2_f32_bf16 v72, v28, v59, v72
    v_dot2_f32_bf16 v73, v28, v64, v73
    v_dot2_f32_bf16 v74, v29, v59, v74
    v_dot2_f32_bf16 v75, v29, v64, v75
    v_dot2_f32_bf16 v76, v30, v59, v76
    v_dot2_f32_bf16 v77, v30, v64, v77
    v_dot2_f32_bf16 v78, v31, v59, v78
    v_dot2_f32_bf16 v79, v31, v64, v79
    s_waitcnt vmcnt(0)
    v_dot2_f32_bf16 v72, v32, v60, v72
    v_dot2_f32_bf16 v73, v32, v65, v73
    v_dot2_f32_bf16 v74, v33, v60, v74
    v_dot2_f32_bf16 v75, v33, v65, v75
    v_dot2_f32_bf16 v76, v34, v60, v76
    v_dot2_f32_bf16 v77, v34, v65, v77
    v_dot2_f32_bf16 v78, v35, v60, v78
    v_dot2_f32_bf16 v79, v35, v65, v79
    v_permlane32_swap_b32 v72, v73
    v_permlane32_swap_b32 v74, v75
    v_permlane32_swap_b32 v76, v77
    v_permlane32_swap_b32 v78, v79
    v_add_f32 v72, v72, v73
    v_add_f32 v74, v74, v75
    v_add_f32 v76, v76, v77
    v_add_f32 v78, v78, v79
    v_permlane16_swap_b32 v72, v74
    s_nop 0
    v_permlane16_swap_b32 v76, v78
    v_add_f32 v72, v72, v74
    v_add_f32 v76, v76, v78
    s_nop 0
    v_add_f32 v72, v72, v72 row_ror:8
    v_add_f32 v76, v76, v76 row_ror:8
    v_mov_b32 v56, v72
    v_mov_b32 v57, v76
    s_nop 0
    v_permlane32_swap_b32 v72, v56
    v_permlane32_swap_b32 v76, v57
    v_cndmask_b32 v60, v72, v76, s[80:81]
    v_cndmask_b32 v61, v56, v57, s[80:81]
    v_lshlrev_b32 v5, 6, v3
    v_bfe_u32 v6, v1, 3, 1
    v_lshl_add_u32 v5, v6, 5, v5
    v_bfe_u32 v6, v1, 4, 1
    v_lshl_add_u32 v5, v6, 4, v5
    s_mul_i32 s8, s3, 4608
    s_lshl_b32 s9, s75, 9
    s_add_u32 s8, s8, s9
    s_add_u32 s8, s8, 135168
    s_mov_b64 exec, 0xffffffff
    v_mov_b32 v62, s76
    v_mov_b32 v63, s77
    buffer_store_dwordx4 v[60:63], v5, s[60:63], s8 offen sc1
    s_mov_b64 exec, -1
    v_mul_u32_u24 v9, 1152, v2
    v_lshl_add_u32 v9, v3, 4, v9
    s_lshl_b32 s8, s75, 7
    v_add_u32 v9, s8, v9
    buffer_load_dwordx4 v[36:39], v9, s[52:55], 0 offen nt
    buffer_load_dwordx4 v[40:43], v9, s[52:55], s73 offen nt
    s_waitcnt vmcnt(1)
    buffer_load_dwordx4 v[44:47], v9, s[56:59], 0 offen nt
    s_waitcnt vmcnt(1)
    buffer_load_dwordx4 v[48:51], v9, s[56:59], s73 offen nt
    s_waitcnt vmcnt(1)
    buffer_load_dwordx4 v[52:55], v9, s[56:59], s74 offen nt
    s_setprio 3
    v_cmp_gt_u32 vcc, 128, v0
    s_and_saveexec_b64 s[12:13], vcc
    s_cbranch_execz L_skip_go_2
    s_lshl_b32 s8, s4, 15
    s_lshl_b32 s9, s5, 11
    s_add_u32 s8, s8, s9
    s_add_u32 s8, s8, 1314816
    s_mov_b32 s11, 0
    s_mov_b64 s[14:15], exec
L_poll_o_3:
    buffer_load_dwordx4 v[56:59], v4, s[60:63], s8 offen sc1
    s_add_u32 s11, s11, 1
    s_waitcnt vmcnt(0)
    v_xor_b32 v60, s76, v58
    v_xor_b32 v5, s77, v59
    v_or_b32 v60, v60, v5
    v_cmp_ne_u32 vcc, 0, v60
    s_and_b64 exec, exec, vcc
    s_cbranch_execz L_poll_done_o_4
    s_cmp_ge_u32 s11, 4096
    s_cbranch_scc1 L_poll_done_o_4
    s_branch L_poll_o_3
L_poll_done_o_4:
    s_nop 7
    s_mov_b64 exec, s[14:15]
    v_lshlrev_b32 v5, 3, v0
    ds_write_b64 v5, v[56:57] offset:23552
L_skip_go_2:
    s_nop 7
    s_mov_b64 exec, -1
    v_subrev_u32 v6, 128, v0
    v_cmp_gt_u32 vcc, 16, v6
    s_and_saveexec_b64 s[12:13], vcc
    s_cbranch_execz L_skip_gs_5
    s_lshl_b32 s8, s4, 9
    s_lshr_b32 s9, s5, 3
    s_lshl_b32 s9, s9, 4
    s_add_u32 s8, s8, s9
    s_add_u32 s8, s8, 1839104
    v_lshlrev_b32 v7, 5, v6
    s_mov_b32 s11, 0
    s_mov_b64 s[14:15], exec
L_poll_s_6:
    buffer_load_dwordx4 v[56:59], v7, s[60:63], s8 offen sc1
    s_add_u32 s11, s11, 1
    s_waitcnt vmcnt(0)
    v_xor_b32 v60, s76, v58
    v_xor_b32 v5, s77, v59
    v_or_b32 v60, v60, v5
    v_cmp_ne_u32 vcc, 0, v60
    s_and_b64 exec, exec, vcc
    s_cbranch_execz L_poll_done_s_7
    s_cmp_ge_u32 s11, 4096
    s_cbranch_scc1 L_poll_done_s_7
    s_branch L_poll_s_6
L_poll_done_s_7:
    s_nop 7
    s_mov_b64 exec, s[14:15]
    v_lshlrev_b32 v5, 3, v6
    ds_write_b64 v5, v[56:57] offset:24576
L_skip_gs_5:
    s_nop 7
    s_mov_b64 exec, -1
    v_subrev_u32 v6, 192, v0
    v_cmp_gt_u32 vcc, 288, v6
    s_and_saveexec_b64 s[12:13], vcc
    s_cbranch_execz L_skip_gg_8
    v_mul_u32_u24 v7, 7282, v6
    v_lshrrev_b32 v7, 16, v7
    v_mul_u32_u24 v8, 9, v7
    v_sub_u32 v8, v6, v8
    v_lshrrev_b32 v9, 4, v7
    v_and_b32 v10, 15, v7
    v_lshlrev_b32 v9, 7, v9
    v_add_u32 v9, v9, v10
    v_mul_u32_u24 v9, 288, v9
    v_add_u32 v9, v9, v8
    v_lshlrev_b32 v9, 4, v9
    s_lshr_b32 s8, s3, 5
    s_mul_i32 s8, s8, 73728
    s_and_b32 s9, s3, 31
    s_mul_i32 s9, s9, 144
    s_add_u32 s8, s8, s9
    s_add_u32 s8, s8, 135168
    s_mov_b32 s11, 0
    s_mov_b64 s[14:15], exec
L_poll_g_9:
    buffer_load_dwordx4 v[56:59], v9, s[60:63], s8 offen sc1
    s_add_u32 s11, s11, 1
    s_waitcnt vmcnt(0)
    v_xor_b32 v60, s76, v58
    v_xor_b32 v5, s77, v59
    v_or_b32 v60, v60, v5
    v_cmp_ne_u32 vcc, 0, v60
    s_and_b64 exec, exec, vcc
    s_cbranch_execz L_poll_done_g_10
    s_cmp_ge_u32 s11, 4096
    s_cbranch_scc1 L_poll_done_g_10
    s_branch L_poll_g_9
L_poll_done_g_10:
    s_nop 7
    s_mov_b64 exec, s[14:15]
    v_lshlrev_b32 v5, 3, v6
    ds_write_b64 v5, v[56:57] offset:24704
L_skip_gg_8:
    s_nop 7
    s_mov_b64 exec, -1
    s_waitcnt lgkmcnt(0)
    s_barrier
    s_cmp_lg_u32 s75, 0
    s_cbranch_scc1 L_skip_oc_11
    v_and_b32 v5, 15, v1
    v_lshlrev_b32 v6, 3, v5
    ds_read_b64 v[56:57], v6 offset:24576
    v_lshlrev_b32 v6, 6, v5
    v_lshrrev_b32 v7, 4, v1
    v_lshl_add_u32 v6, v7, 4, v6
    ds_read_b128 v[60:63], v6 offset:23552
    s_waitcnt lgkmcnt(0)
    v_mov_b32 v64, v56
    s_nop 1
    v_max_f32 v64, v64, v64 row_ror:8
    s_nop 1
    v_max_f32 v64, v64, v64 row_ror:4
    s_nop 1
    v_max_f32 v64, v64, v64 row_ror:2
    s_nop 1
    v_max_f32 v64, v64, v64 row_ror:1
    v_sub_f32 v58, v56, v64
    v_exp_f32 v58, v58
    s_nop 0
    v_mul_f32 v59, v58, v57
    v_mul_f32 v60, v60, v58
    v_mul_f32 v61, v61, v58
    v_mul_f32 v62, v62, v58
    v_mul_f32 v63, v63, v58
    v_add_f32 v59, v59, v59 row_ror:8
    v_add_f32 v60, v60, v60 row_ror:8
    v_add_f32 v61, v61, v61 row_ror:8
    v_add_f32 v62, v62, v62 row_ror:8
    v_add_f32 v63, v63, v63 row_ror:8
    v_add_f32 v59, v59, v59 row_ror:4
    v_add_f32 v60, v60, v60 row_ror:4
    v_add_f32 v61, v61, v61 row_ror:4
    v_add_f32 v62, v62, v62 row_ror:4
    v_add_f32 v63, v63, v63 row_ror:4
    v_add_f32 v59, v59, v59 row_ror:2
    v_add_f32 v60, v60, v60 row_ror:2
    v_add_f32 v61, v61, v61 row_ror:2
    v_add_f32 v62, v62, v62 row_ror:2
    v_add_f32 v63, v63, v63 row_ror:2
    v_add_f32 v59, v59, v59 row_ror:1
    v_add_f32 v60, v60, v60 row_ror:1
    v_add_f32 v61, v61, v61 row_ror:1
    v_add_f32 v62, v62, v62 row_ror:1
    v_add_f32 v63, v63, v63 row_ror:1
    v_rcp_f32 v65, v59
    s_nop 0
    v_mul_f32 v60, v60, v65
    v_mul_f32 v61, v61, v65
    v_mul_f32 v62, v62, v65
    v_mul_f32 v63, v63, v65
    v_cvt_pk_bf16_f32 v60, v60, 0
    v_cvt_pk_bf16_f32 v61, v61, 0
    v_cvt_pk_bf16_f32 v62, v62, 0
    v_cvt_pk_bf16_f32 v63, v63, 0
    v_lshlrev_b32 v6, 4, v7
    ds_write_b128 v6, v[60:63] offset:27008
    v_mov_b32 v65, 0
    v_and_b32 v6, 7, v5
    v_lshlrev_b32 v6, 2, v6
    ds_write_b32 v6, v65 offset:27144
L_skip_oc_11:
    s_nop 7
    v_subrev_u32 v6, 64, v0
    v_cmp_gt_u32 vcc, 288, v6
    s_and_saveexec_b64 s[12:13], vcc
    s_cbranch_execz L_skip_hc_12
    v_lshrrev_b32 v7, 4, v6
    v_and_b32 v8, 15, v6
    v_mul_u32_u24 v8, 72, v8
    v_lshl_add_u32 v8, v7, 2, v8
    ds_read_b32 v56, v8 offset:24704
    ds_read_b32 v57, v8 offset:25856
    s_waitcnt lgkmcnt(0)
    v_add_f32 v56, v56, v56 row_ror:8
    v_add_f32 v57, v57, v57 row_ror:8
    s_nop 0
    v_add_f32 v56, v56, v56 row_ror:4
    v_add_f32 v57, v57, v57 row_ror:4
    s_nop 0
    v_add_f32 v56, v56, v56 row_ror:2
    v_add_f32 v57, v57, v57 row_ror:2
    s_nop 0
    v_add_f32 v56, v56, v56 row_ror:1
    v_add_f32 v57, v57, v57 row_ror:1
    v_cvt_pk_bf16_f32 v56, v56, 0
    v_lshlrev_b32 v56, 16, v56
    v_cvt_pk_bf16_f32 v57, v57, 0
    v_lshlrev_b32 v57, 16, v57
    v_mul_f32 v59, 0xbfb8aa3b, v56
    v_exp_f32 v59, v59
    s_nop 0
    v_add_f32 v59, 1.0, v59
    v_rcp_f32 v59, v59
    s_nop 0
    v_mul_f32 v58, v56, v59
    v_cvt_pk_bf16_f32 v58, v58, 0
    v_lshlrev_b32 v58, 16, v58
    v_mul_f32 v58, v58, v57
    v_cvt_pk_bf16_f32 v58, v58, 0
    v_lshlrev_b32 v8, 2, v7
    ds_write_b32 v8, v58 offset:27072
L_skip_hc_12:
    s_nop 7
    s_mov_b64 exec, -1
    s_waitcnt lgkmcnt(0)
    s_barrier
    v_lshlrev_b32 v66, 2, v2
    ds_read_b32 v56, v66 offset:27008
    ds_read_b32 v57, v66 offset:27040
    ds_read_b32 v58, v66 offset:27072
    ds_read_b32 v59, v66 offset:27104
    ds_read_b32 v60, v66 offset:27136
    s_waitcnt lgkmcnt(0)
    v_lshlrev_b32 v61, 16, v56
    v_lshlrev_b32 v62, 16, v57
    v_lshlrev_b32 v63, 16, v58
    v_lshlrev_b32 v64, 16, v59
    v_lshlrev_b32 v65, 16, v60
    s_waitcnt vmcnt(4)
    v_dot2_f32_bf16 v16, v36, v56, 0
    v_dot2_f32_bf16 v17, v36, v61, 0
    v_dot2_f32_bf16 v18, v37, v56, 0
    v_dot2_f32_bf16 v19, v37, v61, 0
    v_dot2_f32_bf16 v20, v38, v56, 0
    v_dot2_f32_bf16 v21, v38, v61, 0
    v_dot2_f32_bf16 v22, v39, v56, 0
    v_dot2_f32_bf16 v23, v39, v61, 0
    s_waitcnt vmcnt(3)
    v_dot2_f32_bf16 v16, v40, v57, v16
    v_dot2_f32_bf16 v17, v40, v62, v17
    v_dot2_f32_bf16 v18, v41, v57, v18
    v_dot2_f32_bf16 v19, v41, v62, v19
    v_dot2_f32_bf16 v20, v42, v57, v20
    v_dot2_f32_bf16 v21, v42, v62, v21
    v_dot2_f32_bf16 v22, v43, v57, v22
    v_dot2_f32_bf16 v23, v43, v62, v23
    s_waitcnt vmcnt(2)
    v_dot2_f32_bf16 v24, v44, v58, 0
    v_dot2_f32_bf16 v25, v44, v63, 0
    v_dot2_f32_bf16 v26, v45, v58, 0
    v_dot2_f32_bf16 v27, v45, v63, 0
    v_dot2_f32_bf16 v28, v46, v58, 0
    v_dot2_f32_bf16 v29, v46, v63, 0
    v_dot2_f32_bf16 v30, v47, v58, 0
    v_dot2_f32_bf16 v31, v47, v63, 0
    s_waitcnt vmcnt(1)
    v_dot2_f32_bf16 v24, v48, v59, v24
    v_dot2_f32_bf16 v25, v48, v64, v25
    v_dot2_f32_bf16 v26, v49, v59, v26
    v_dot2_f32_bf16 v27, v49, v64, v27
    v_dot2_f32_bf16 v28, v50, v59, v28
    v_dot2_f32_bf16 v29, v50, v64, v29
    v_dot2_f32_bf16 v30, v51, v59, v30
    v_dot2_f32_bf16 v31, v51, v64, v31
    s_waitcnt vmcnt(0)
    v_dot2_f32_bf16 v24, v52, v60, v24
    v_dot2_f32_bf16 v25, v52, v65, v25
    v_dot2_f32_bf16 v26, v53, v60, v26
    v_dot2_f32_bf16 v27, v53, v65, v27
    v_dot2_f32_bf16 v28, v54, v60, v28
    v_dot2_f32_bf16 v29, v54, v65, v29
    v_dot2_f32_bf16 v30, v55, v60, v30
    v_dot2_f32_bf16 v31, v55, v65, v31
    v_permlane32_swap_b32 v16, v17
    v_permlane32_swap_b32 v18, v19
    v_permlane32_swap_b32 v20, v21
    v_permlane32_swap_b32 v22, v23
    v_add_f32 v16, v16, v17
    v_add_f32 v18, v18, v19
    v_add_f32 v20, v20, v21
    v_add_f32 v22, v22, v23
    v_permlane16_swap_b32 v16, v18
    s_nop 0
    v_permlane16_swap_b32 v20, v22
    v_add_f32 v16, v16, v18
    v_add_f32 v20, v20, v22
    s_nop 0
    v_add_f32 v16, v16, v16 row_ror:8
    v_add_f32 v20, v20, v20 row_ror:8
    v_permlane32_swap_b32 v24, v25
    v_permlane32_swap_b32 v26, v27
    v_permlane32_swap_b32 v28, v29
    v_permlane32_swap_b32 v30, v31
    v_add_f32 v24, v24, v25
    v_add_f32 v26, v26, v27
    v_add_f32 v28, v28, v29
    v_add_f32 v30, v30, v31
    v_permlane16_swap_b32 v24, v26
    s_nop 0
    v_permlane16_swap_b32 v28, v30
    v_add_f32 v24, v24, v26
    v_add_f32 v28, v28, v30
    s_nop 0
    v_add_f32 v24, v24, v24 row_ror:8
    v_add_f32 v28, v28, v28 row_ror:8
    v_cndmask_b32 v68, v16, v20, s[80:81]
    v_cndmask_b32 v69, v24, v28, s[80:81]
    s_lshl_b32 s8, s75, 3
    v_add_u32 v5, s8, v3
    v_lshlrev_b32 v5, 15, v5
    v_bfe_u32 v6, v1, 3, 1
    v_lshl_add_u32 v5, v6, 6, v5
    v_bfe_u32 v6, v1, 4, 1
    v_lshl_add_u32 v5, v6, 5, v5
    v_bfe_u32 v6, v1, 5, 1
    v_lshl_add_u32 v5, v6, 4, v5
    s_lshl_b32 s8, s3, 7
    s_add_u32 s8, s8, 2097152
    v_mov_b32 v70, s76
    v_mov_b32 v71, s77
    buffer_store_dwordx4 v[68:71], v5, s[60:63], s8 offen sc1
    s_cmp_ge_u32 s3, 72
    s_cbranch_scc1 L_skip_final_13
    s_lshl_b32 s8, s3, 15
    s_add_u32 s8, s8, 2097152
    s_add_u32 s9, s8, 8192
    s_add_u32 s10, s8, 16384
    s_add_u32 s82, s8, 24576
    s_lshl_b32 s83, s3, 4
    v_and_b32 v7, 7, v1
    v_lshlrev_b32 v7, 1, v7
    v_add_u32 v7, s83, v7
    buffer_load_ushort v15, v7, s[40:43], 0 offen
    v_cmp_gt_u32 vcc, 512, v0
    s_and_saveexec_b64 s[12:13], vcc
    s_cbranch_execz L_skip_fg_14
    s_mov_b32 s11, 0
    s_mov_b64 s[14:15], exec
    s_mov_b64 s[16:17], exec
    s_mov_b64 s[18:19], exec
    s_mov_b64 s[20:21], exec
    s_mov_b64 s[22:23], exec
    s_nop 4
L_pollm_f_15:
    s_mov_b64 exec, s[16:17]
    s_cbranch_execz L_pollm_sk0_f_17
    buffer_load_dwordx4 v[56:59], v4, s[60:63], s8 offen sc1
L_pollm_sk0_f_17:
    s_mov_b64 exec, s[18:19]
    s_cbranch_execz L_pollm_sk1_f_18
    buffer_load_dwordx4 v[60:63], v4, s[60:63], s9 offen sc1
L_pollm_sk1_f_18:
    s_mov_b64 exec, s[20:21]
    s_cbranch_execz L_pollm_sk2_f_19
    buffer_load_dwordx4 v[64:67], v4, s[60:63], s10 offen sc1
L_pollm_sk2_f_19:
    s_mov_b64 exec, s[22:23]
    s_cbranch_execz L_pollm_sk3_f_20
    buffer_load_dwordx4 v[68:71], v4, s[60:63], s82 offen sc1
L_pollm_sk3_f_20:
    s_add_u32 s11, s11, 1
    s_waitcnt vmcnt(0)
    s_mov_b64 exec, s[16:17]
    v_xor_b32 v72, s76, v58
    v_xor_b32 v5, s77, v59
    v_or_b32 v72, v72, v5
    v_cmp_ne_u32 vcc, 0, v72
    s_and_b64 s[16:17], s[16:17], vcc
    s_mov_b64 exec, s[18:19]
    v_xor_b32 v72, s76, v62
    v_xor_b32 v5, s77, v63
    v_or_b32 v72, v72, v5
    v_cmp_ne_u32 vcc, 0, v72
    s_and_b64 s[18:19], s[18:19], vcc
    s_mov_b64 exec, s[20:21]
    v_xor_b32 v72, s76, v66
    v_xor_b32 v5, s77, v67
    v_or_b32 v72, v72, v5
    v_cmp_ne_u32 vcc, 0, v72
    s_and_b64 s[20:21], s[20:21], vcc
    s_mov_b64 exec, s[22:23]
    v_xor_b32 v72, s76, v70
    v_xor_b32 v5, s77, v71
    v_or_b32 v72, v72, v5
    v_cmp_ne_u32 vcc, 0, v72
    s_and_b64 s[22:23], s[22:23], vcc
    s_or_b64 s[12:13], s[16:17], s[18:19]
    s_or_b64 s[12:13], s[12:13], s[20:21]
    s_or_b64 s[12:13], s[12:13], s[22:23]
    s_cbranch_scc0 L_pollm_done_f_16
    s_cmp_ge_u32 s11, 4096
    s_cbranch_scc1 L_pollm_done_f_16
    s_branch L_pollm_f_15
L_pollm_done_f_16:
    s_nop 7
    s_mov_b64 exec, s[14:15]
    v_add_f32 v56, v56, v60
    v_add_f32 v56, v56, v64
    v_add_f32 v56, v56, v68
    v_add_f32 v57, v57, v61
    v_add_f32 v57, v57, v65
    v_add_f32 v57, v57, v69
    v_add_f32 v56, v56, v56 row_ror:8
    s_nop 0
    v_add_f32 v57, v57, v57 row_ror:8
    s_nop 1
    v_permlane32_swap_b32 v56, v57
    v_add_f32 v56, v56, v57
    v_mov_b32 v73, v56
    s_nop 1
    v_permlane16_swap_b32 v56, v73
    v_add_f32 v56, v56, v73
    v_lshrrev_b32 v5, 5, v1
    v_lshlrev_b32 v5, 5, v5
    v_and_b32 v6, 7, v1
    v_lshl_add_u32 v5, v6, 2, v5
    s_lshl_b32 s10, s75, 6
    v_add_u32 v5, s10, v5
    ds_write_b32 v5, v56 offset:5120
L_skip_fg_14:
    s_nop 7
    s_mov_b64 exec, -1
    s_waitcnt lgkmcnt(0)
    s_barrier
    s_cmp_lg_u32 s75, 0
    s_cbranch_scc1 L_skip_fin2_21
    v_lshlrev_b32 v5, 2, v1
    ds_read_b32 v66, v5 offset:5120
    ds_read_b32 v67, v5 offset:5376
    s_waitcnt lgkmcnt(0)
    v_add_f32 v66, v66, v67
    v_mov_b32 v73, v66
    s_nop 1
    v_permlane32_swap_b32 v66, v73
    v_add_f32 v66, v66, v73
    v_mov_b32 v73, v66
    s_nop 1
    v_permlane16_swap_b32 v66, v73
    v_add_f32 v66, v66, v73
    s_nop 1
    v_mov_b32 v67, v66 row_shl:8
    v_cvt_pk_bf16_f32 v66, v66, 0
    v_lshlrev_b32 v66, 16, v66
    v_cvt_pk_bf16_f32 v67, v67, 0
    v_lshlrev_b32 v67, 16, v67
    v_mul_f32 v68, 0xbfb8aa3b, v67
    v_exp_f32 v68, v68
    s_nop 0
    v_add_f32 v68, 1.0, v68
    v_rcp_f32 v68, v68
    s_nop 0
    v_mul_f32 v73, v67, v68
    v_cvt_pk_bf16_f32 v73, v73, 0
    v_lshlrev_b32 v73, 16, v73
    v_mul_f32 v73, v66, v73
    v_cvt_pk_bf16_f32 v73, v73, 0
    v_lshlrev_b32 v73, 16, v73
    v_lshlrev_b32 v68, 16, v15
    v_add_f32 v73, v68, v73
    v_cvt_pk_bf16_f32 v73, v73, 0
    s_mov_b64 exec, 0xff
    buffer_store_short v73, v7, s[64:67], 0 offen
    s_mov_b64 exec, -1
    s_cmp_lg_u32 s3, 0
    s_cbranch_scc1 L_skip_epoch_22
    v_mov_b32 v8, s76
    v_mov_b32 v9, s77
    v_mov_b32 v10, 0
    s_mov_b64 exec, 1
    buffer_store_dwordx2 v[8:9], v10, s[60:63], 0 offen sc1
    s_mov_b64 exec, -1
L_skip_epoch_22:
    s_nop 7
L_skip_fin2_21:
    s_nop 7
L_skip_final_13:
    s_nop 7
    s_branch L_exit
L_role_kv:
    s_nop 7
    s_lshr_b32 s4, s3, 4
    s_and_b32 s5, s3, 15
    s_mov_b32 s80, 0x3e0293ee
    s_lshl_b32 s8, s4, 21
    s_lshl_b32 s9, s5, 15
    s_add_u32 s8, s8, s9
    s_add_u32 s8, s8, 1572864
    s_add_u32 s44, s18, s8
    s_addc_u32 s45, s19, 0
    s_mov_b32 s46, 32768
    s_mov_b32 s47, 0x00020000
    s_add_u32 s48, s20, s8
    s_addc_u32 s49, s21, 0
    s_mov_b32 s50, 32768
    s_mov_b32 s51, 0x00020000
    s_setprio 2
    v_mov_b32 v12, 0
    buffer_load_dwordx2 v[10:11], v12, s[60:63], 0 offen sc1
    s_cmp_ge_u32 s75, 8
    s_cbranch_scc1 L_kv_noload_23
    v_and_b32 v5, 7, v1
    v_lshrrev_b32 v6, 1, v5
    v_and_b32 v7, 1, v5
    v_mov_b32 v8, 0xffff
    v_lshlrev_b32 v7, 4, v7
    v_lshlrev_b32 v8, v7, v8
    v_mov_b32 v72, s80
    v_cmp_eq_u32 vcc, 0, v6
    s_nop 1
    v_cndmask_b32 v76, 0, v8, vcc
    v_cmp_eq_u32 vcc, 1, v6
    s_nop 1
    v_cndmask_b32 v77, 0, v8, vcc
    v_cmp_eq_u32 vcc, 2, v6
    s_nop 1
    v_cndmask_b32 v78, 0, v8, vcc
    v_cmp_eq_u32 vcc, 3, v6
    s_nop 1
    v_cndmask_b32 v79, 0, v8, vcc
    v_lshrrev_b32 v5, 6, v0
    v_lshlrev_b32 v5, 12, v5
    v_and_b32 v6, 15, v1
    v_lshrrev_b32 v7, 4, v1
    v_lshl_add_u32 v8, v6, 8, v5
    v_lshl_add_u32 v8, v7, 4, v8
    v_lshl_add_u32 v9, v7, 10, v5
    v_lshl_add_u32 v9, v6, 4, v9
    buffer_load_dwordx4 v[16:19], v8, s[44:47], 0 offen nt
    buffer_load_dwordx4 v[20:23], v8, s[44:47], 0 offen offset:64 nt
    s_waitcnt vmcnt(1)
    buffer_load_dwordx4 v[24:27], v8, s[44:47], 0 offen offset:128 nt
    s_waitcnt vmcnt(1)
    buffer_load_dwordx4 v[28:31], v8, s[44:47], 0 offen offset:192 nt
    s_waitcnt vmcnt(1)
    buffer_load_dwordx4 v[32:35], v9, s[48:51], 0 offen nt
    s_waitcnt vmcnt(1)
    buffer_load_dwordx4 v[36:39], v9, s[48:51], 0 offen offset:256 nt
    s_waitcnt vmcnt(1)
    buffer_load_dwordx4 v[40:43], v9, s[48:51], 0 offen offset:512 nt
    s_waitcnt vmcnt(1)
    buffer_load_dwordx4 v[44:47], v9, s[48:51], 0 offen offset:768 nt
L_kv_noload_23:
    s_nop 7
    s_waitcnt vmcnt(7)
    s_cmp_lt_u32 s75, 8
    s_cbranch_scc1 L_kv_w8_24
    s_waitcnt vmcnt(0)
L_kv_w8_24:
    s_nop 7
    v_readfirstlane_b32 s76, v10
    v_readfirstlane_b32 s77, v11
    s_add_u32 s76, s76, 1
    s_addc_u32 s77, s77, 0
    s_cmp_lg_u32 s75, 8
    s_cbranch_scc1 L_skip_gq_25
    v_lshrrev_b32 v6, 5, v1
    v_lshlrev_b32 v6, 11, v6
    v_and_b32 v7, 31, v1
    v_lshl_add_u32 v6, v7, 4, v6
    s_lshl_b32 s8, s4, 13
    s_add_u32 s8, s8, 4096
    s_add_u32 s9, s8, 4096
    s_mov_b32 s11, 0
    s_mov_b64 s[14:15], exec
    s_mov_b64 s[16:17], exec
    s_mov_b64 s[18:19], exec
    s_mov_b64 s[20:21], exec
    s_mov_b64 s[22:23], exec
    s_mov_b64 s[24:25], exec
    s_mov_b64 s[26:27], exec
    s_mov_b64 s[28:29], exec
    s_mov_b64 s[30:31], exec
    s_nop 4
L_pollm_q_26:
    s_mov_b64 exec, s[16:17]
    s_cbranch_execz L_pollm_sk0_q_28
    buffer_load_dwordx4 v[48:51], v6, s[60:63], s8 offen sc1
L_pollm_sk0_q_28:
    s_mov_b64 exec, s[18:19]
    s_cbranch_execz L_pollm_sk1_q_29
    buffer_load_dwordx4 v[52:55], v6, s[60:63], s8 offen offset:512 sc1
L_pollm_sk1_q_29:
    s_mov_b64 exec, s[20:21]
    s_cbranch_execz L_pollm_sk2_q_30
    buffer_load_dwordx4 v[56:59], v6, s[60:63], s8 offen offset:1024 sc1
L_pollm_sk2_q_30:
    s_mov_b64 exec, s[22:23]
    s_cbranch_execz L_pollm_sk3_q_31
    buffer_load_dwordx4 v[60:63], v6, s[60:63], s8 offen offset:1536 sc1
L_pollm_sk3_q_31:
    s_mov_b64 exec, s[24:25]
    s_cbranch_execz L_pollm_sk4_q_32
    buffer_load_dwordx4 v[64:67], v6, s[60:63], s9 offen sc1
L_pollm_sk4_q_32:
    s_mov_b64 exec, s[26:27]
    s_cbranch_execz L_pollm_sk5_q_33
    buffer_load_dwordx4 v[68:71], v6, s[60:63], s9 offen offset:512 sc1
L_pollm_sk5_q_33:
    s_mov_b64 exec, s[28:29]
    s_cbranch_execz L_pollm_sk6_q_34
    buffer_load_dwordx4 v[72:75], v6, s[60:63], s9 offen offset:1024 sc1
L_pollm_sk6_q_34:
    s_mov_b64 exec, s[30:31]
    s_cbranch_execz L_pollm_sk7_q_35
    buffer_load_dwordx4 v[76:79], v6, s[60:63], s9 offen offset:1536 sc1
L_pollm_sk7_q_35:
    s_add_u32 s11, s11, 1
    s_waitcnt vmcnt(0)
    s_mov_b64 exec, s[16:17]
    v_xor_b32 v15, s76, v50
    v_xor_b32 v5, s77, v51
    v_or_b32 v15, v15, v5
    v_cmp_ne_u32 vcc, 0, v15
    s_and_b64 s[16:17], s[16:17], vcc
    s_mov_b64 exec, s[18:19]
    v_xor_b32 v15, s76, v54
    v_xor_b32 v5, s77, v55
    v_or_b32 v15, v15, v5
    v_cmp_ne_u32 vcc, 0, v15
    s_and_b64 s[18:19], s[18:19], vcc
    s_mov_b64 exec, s[20:21]
    v_xor_b32 v15, s76, v58
    v_xor_b32 v5, s77, v59
    v_or_b32 v15, v15, v5
    v_cmp_ne_u32 vcc, 0, v15
    s_and_b64 s[20:21], s[20:21], vcc
    s_mov_b64 exec, s[22:23]
    v_xor_b32 v15, s76, v62
    v_xor_b32 v5, s77, v63
    v_or_b32 v15, v15, v5
    v_cmp_ne_u32 vcc, 0, v15
    s_and_b64 s[22:23], s[22:23], vcc
    s_mov_b64 exec, s[24:25]
    v_xor_b32 v15, s76, v66
    v_xor_b32 v5, s77, v67
    v_or_b32 v15, v15, v5
    v_cmp_ne_u32 vcc, 0, v15
    s_and_b64 s[24:25], s[24:25], vcc
    s_mov_b64 exec, s[26:27]
    v_xor_b32 v15, s76, v70
    v_xor_b32 v5, s77, v71
    v_or_b32 v15, v15, v5
    v_cmp_ne_u32 vcc, 0, v15
    s_and_b64 s[26:27], s[26:27], vcc
    s_mov_b64 exec, s[28:29]
    v_xor_b32 v15, s76, v74
    v_xor_b32 v5, s77, v75
    v_or_b32 v15, v15, v5
    v_cmp_ne_u32 vcc, 0, v15
    s_and_b64 s[28:29], s[28:29], vcc
    s_mov_b64 exec, s[30:31]
    v_xor_b32 v15, s76, v78
    v_xor_b32 v5, s77, v79
    v_or_b32 v15, v15, v5
    v_cmp_ne_u32 vcc, 0, v15
    s_and_b64 s[30:31], s[30:31], vcc
    s_or_b64 s[12:13], s[16:17], s[18:19]
    s_or_b64 s[12:13], s[12:13], s[20:21]
    s_or_b64 s[12:13], s[12:13], s[22:23]
    s_or_b64 s[12:13], s[12:13], s[24:25]
    s_or_b64 s[12:13], s[12:13], s[26:27]
    s_or_b64 s[12:13], s[12:13], s[28:29]
    s_or_b64 s[12:13], s[12:13], s[30:31]
    s_cbranch_scc0 L_pollm_done_q_27
    s_cmp_ge_u32 s11, 4096
    s_cbranch_scc1 L_pollm_done_q_27
    s_branch L_pollm_q_26
L_pollm_done_q_27:
    s_nop 7
    s_mov_b64 exec, s[14:15]
    v_add_f32 v48, v48, v52
    v_add_f32 v48, v48, v56
    v_add_f32 v48, v48, v60
    v_add_f32 v49, v49, v53
    v_add_f32 v49, v49, v57
    v_add_f32 v49, v49, v61
    v_cvt_pk_bf16_f32 v48, v48, v49
    v_add_f32 v64, v64, v68
    v_add_f32 v64, v64, v72
    v_add_f32 v64, v64, v76
    v_add_f32 v65, v65, v69
    v_add_f32 v65, v65, v73
    v_add_f32 v65, v65, v77
    v_cvt_pk_bf16_f32 v64, v64, v65
    v_lshlrev_b32 v5, 2, v1
    ds_write_b32 v5, v48 offset:0
    ds_write_b32 v5, v64 offset:256
L_skip_gq_25:
    s_nop 7
    s_waitcnt lgkmcnt(0)
    s_barrier
    s_cmp_ge_u32 s75, 8
    s_cbranch_scc1 L_skip_attn_36
    v_bfe_u32 v5, v1, 3, 1
    v_lshlrev_b32 v5, 8, v5
    v_lshrrev_b32 v6, 4, v1
    v_lshl_add_u32 v5, v6, 4, v5
    ds_read_b128 v[48:51], v5 offset:0
    ds_read_b128 v[52:55], v5 offset:64
    ds_read_b128 v[56:59], v5 offset:128
    ds_read_b128 v[60:63], v5 offset:192
    s_waitcnt vmcnt(4)
    s_waitcnt lgkmcnt(3)
    v_mfma_f32_16x16x32_bf16 v[64:67], v[16:19], v[48:51], 0
    s_waitcnt lgkmcnt(2)
    v_mfma_f32_16x16x32_bf16 v[64:67], v[20:23], v[52:55], v[64:67]
    s_waitcnt lgkmcnt(1)
    v_mfma_f32_16x16x32_bf16 v[64:67], v[24:27], v[56:59], v[64:67]
    s_waitcnt lgkmcnt(0)
    v_mfma_f32_16x16x32_bf16 v[64:67], v[28:31], v[60:63], v[64:67]
    s_nop 7
    v_max3_f32 v68, v64, v65, v66
    v_max_f32 v68, v68, v67
    v_mov_b32 v69, v68
    s_nop 1
    v_permlane32_swap_b32 v68, v69
    v_max_f32 v68, v68, v69
    v_mov_b32 v69, v68
    s_nop 1
    v_permlane16_swap_b32 v68, v69
    v_max_f32 v68, v68, v69
    v_mul_f32 v70, v68, v72
    v_fma_f32 v64, v64, v72, -v70
    v_fma_f32 v65, v65, v72, -v70
    v_fma_f32 v66, v66, v72, -v70
    v_fma_f32 v67, v67, v72, -v70
    v_exp_f32 v64, v64
    v_exp_f32 v65, v65
    v_exp_f32 v66, v66
    v_exp_f32 v67, v67
    s_waitcnt vmcnt(0)
    v_cvt_pk_bf16_f32 v74, v64, v64
    v_and_b32 v48, v74, v76
    v_and_b32 v49, v74, v77
    v_and_b32 v50, v74, v78
    v_and_b32 v51, v74, v79
    s_nop 1
    v_mfma_f32_16x16x32_bf16 v[56:59], v[32:35], v[48:51], 0
    v_cvt_pk_bf16_f32 v74, v65, v65
    v_and_b32 v52, v74, v76
    v_and_b32 v53, v74, v77
    v_and_b32 v54, v74, v78
    v_and_b32 v55, v74, v79
    s_nop 1
    v_mfma_f32_16x16x32_bf16 v[56:59], v[36:39], v[52:55], v[56:59]
    v_cvt_pk_bf16_f32 v74, v66, v66
    v_and_b32 v48, v74, v76
    v_and_b32 v49, v74, v77
    v_and_b32 v50, v74, v78
    v_and_b32 v51, v74, v79
    s_nop 1
    v_mfma_f32_16x16x32_bf16 v[56:59], v[40:43], v[48:51], v[56:59]
    v_cvt_pk_bf16_f32 v74, v67, v67
    v_and_b32 v52, v74, v76
    v_and_b32 v53, v74, v77
    v_and_b32 v54, v74, v78
    v_and_b32 v55, v74, v79
    s_nop 1
    v_mfma_f32_16x16x32_bf16 v[56:59], v[44:47], v[52:55], v[56:59]
    v_add_f32 v73, v64, v65
    v_add_f32 v73, v73, v66
    v_add_f32 v73, v73, v67
    v_mov_b32 v69, v73
    s_nop 1
    v_permlane32_swap_b32 v73, v69
    v_add_f32 v73, v73, v69
    v_mov_b32 v69, v73
    s_nop 1
    v_permlane16_swap_b32 v73, v69
    v_add_f32 v73, v73, v69
    s_lshl_b32 s8, s75, 10
    v_lshlrev_b32 v5, 2, v1
    v_add_u32 v5, s8, v5
    ds_write_b32 v5, v56 offset:1024
    ds_write_b32 v5, v57 offset:1280
    ds_write_b32 v5, v58 offset:1536
    ds_write_b32 v5, v59 offset:1792
    v_mov_b32 v71, v73
    s_lshl_b32 s8, s75, 4
    v_add_u32 v5, s8, v1
    s_mov_b64 exec, 0x101
    ds_write_b64 v5, v[70:71] offset:9216
    s_mov_b64 exec, -1
L_skip_attn_36:
    s_nop 7
    s_waitcnt lgkmcnt(0)
    s_barrier
    v_cmp_gt_u32 vcc, 128, v0
    s_and_saveexec_b64 s[12:13], vcc
    s_cbranch_execz L_skip_mrg_37
    v_bfe_u32 v5, v0, 2, 1
    v_lshlrev_b32 v5, 3, v5
    ds_read_b64 v[48:49], v5 offset:9216
    ds_read_b64 v[50:51], v5 offset:9232
    ds_read_b64 v[52:53], v5 offset:9248
    ds_read_b64 v[54:55], v5 offset:9264
    ds_read_b64 v[56:57], v5 offset:9280
    ds_read_b64 v[58:59], v5 offset:9296
    ds_read_b64 v[60:61], v5 offset:9312
    ds_read_b64 v[62:63], v5 offset:9328
    v_lshrrev_b32 v6, 5, v0
    v_lshlrev_b32 v6, 8, v6
    v_and_b32 v7, 31, v0
    v_lshl_add_u32 v6, v7, 3, v6
    ds_read_b64 v[16:17], v6 offset:1024
    ds_read_b64 v[18:19], v6 offset:2048
    ds_read_b64 v[20:21], v6 offset:3072
    ds_read_b64 v[22:23], v6 offset:4096
    ds_read_b64 v[24:25], v6 offset:5120
    ds_read_b64 v[26:27], v6 offset:6144
    ds_read_b64 v[28:29], v6 offset:7168
    ds_read_b64 v[30:31], v6 offset:8192
    s_waitcnt lgkmcnt(8)
    v_max3_f32 v76, v48, v50, v52
    v_max3_f32 v76, v76, v54, v56
    v_max3_f32 v76, v76, v58, v60
    v_max_f32 v76, v76, v62
    v_sub_f32 v64, v48, v76
    v_sub_f32 v65, v50, v76
    v_sub_f32 v66, v52, v76
    v_sub_f32 v67, v54, v76
    v_sub_f32 v68, v56, v76
    v_sub_f32 v69, v58, v76
    v_sub_f32 v70, v60, v76
    v_sub_f32 v71, v62, v76
    v_exp_f32 v64, v64
    v_exp_f32 v65, v65
    v_exp_f32 v66, v66
    v_exp_f32 v67, v67
    v_exp_f32 v68, v68
    v_exp_f32 v69, v69
    v_exp_f32 v70, v70
    v_exp_f32 v71, v71
    s_waitcnt lgkmcnt(0)
    v_mul_f32 v72, v64, v16
    v_mul_f32 v73, v64, v17
    v_fmac_f32 v72, v65, v18
    v_fmac_f32 v73, v65, v19
    v_fmac_f32 v72, v66, v20
    v_fmac_f32 v73, v66, v21
    v_fmac_f32 v72, v67, v22
    v_fmac_f32 v73, v67, v23
    v_fmac_f32 v72, v68, v24
    v_fmac_f32 v73, v68, v25
    v_fmac_f32 v72, v69, v26
    v_fmac_f32 v73, v69, v27
    v_fmac_f32 v72, v70, v28
    v_fmac_f32 v73, v70, v29
    v_fmac_f32 v72, v71, v30
    v_fmac_f32 v73, v71, v31
    v_bfe_u32 v5, v0, 2, 1
    v_lshlrev_b32 v5, 3, v5
    v_bfe_u32 v6, v0, 3, 2
    v_lshl_add_u32 v5, v6, 1, v5
    v_bfe_u32 v6, v0, 6, 1
    v_add_u32 v5, v5, v6
    v_lshlrev_b32 v5, 11, v5
    v_bfe_u32 v6, v0, 5, 1
    v_lshl_add_u32 v5, v6, 6, v5
    v_and_b32 v6, 3, v0
    v_lshl_add_u32 v5, v6, 4, v5
    s_lshl_b32 s8, s4, 15
    s_lshl_b32 s9, s5, 7
    s_add_u32 s8, s8, s9
    s_add_u32 s8, s8, 1314816
    v_mov_b32 v74, s76
    v_mov_b32 v75, s77
    buffer_store_dwordx4 v[72:75], v5, s[60:63], s8 offen sc1
    v_and_b32 v6, 0x7b, v0
    v_cmp_eq_u32 vcc, 0, v6
    s_and_saveexec_b64 s[14:15], vcc
    s_cbranch_execz L_skip_pst_38
    v_mov_b32 v48, v76
    v_mul_f32 v49, v64, v49
    v_fmac_f32 v49, v65, v51
    v_fmac_f32 v49, v66, v53
    v_fmac_f32 v49, v67, v55
    v_fmac_f32 v49, v68, v57
    v_fmac_f32 v49, v69, v59
    v_fmac_f32 v49, v70, v61
    v_fmac_f32 v49, v71, v63
    v_bfe_u32 v5, v0, 2, 1
    v_lshlrev_b32 v5, 4, v5
    s_lshl_b32 s8, s3, 5
    s_add_u32 s8, s8, 1839104
    v_mov_b32 v50, s76
    v_mov_b32 v51, s77
    buffer_store_dwordx4 v[48:51], v5, s[60:63], s8 offen sc1
L_skip_pst_38:
    s_nop 7
L_skip_mrg_37:
    s_nop 7
    s_mov_b64 exec, -1
L_exit:
    s_nop 7
    s_endpgm
.section .rodata,"a"
.p2align 6
.amdhsa_kernel recurrent_scan__sliding_block_cached__swiglu_ffn__decode_kernel
  .amdhsa_next_free_vgpr 80
  .amdhsa_next_free_sgpr 88
  .amdhsa_accum_offset 80
  .amdhsa_group_segment_fixed_size 0
  .amdhsa_kernarg_size 96
  .amdhsa_user_sgpr_count 2
  .amdhsa_user_sgpr_kernarg_segment_ptr 1
  .amdhsa_system_sgpr_workgroup_id_x 1
.end_amdhsa_kernel
```
